```python
import torch

def _softmax(x, axis=-1):
    return torch.softmax(x, dim=axis)
def _gelu(x):
    return torch.nn.functional.gelu(x, approximate="tanh")
def _silu(x):
    return torch.nn.functional.silu(x)
def _sigmoid(x):
    return torch.sigmoid(x)
def _layernorm(x, axis=-1, eps=1e-5):
    m = x.mean(dim=axis, keepdim=True)
    v = x.var(dim=axis, keepdim=True, unbiased=False)
    return (x - m) / torch.sqrt(v + eps)
def _scatter_add(tgt, idx, src, axis=0):
    return tgt.clone().index_add_(axis, idx, src)
def _segment_sum(src, seg, n):
    out = torch.zeros((n,) + src.shape[1:], dtype=src.dtype)
    return out.index_add_(0, seg, src)
def _pad(x, pw):
    flat = tuple(v for pair in reversed(pw) for v in pair)
    return torch.nn.functional.pad(x, flat)

kernel_name = 'standalone__self_sup_conv_stem_hubert__speech'

def setup_inputs():

    _w = (lambda a: (lambda t: t.to(torch.bfloat16) if t.is_floating_point() else t)(torch.as_tensor(a)))
    B, T, D, K = 2, 4000, 512, 5
    scale = (1.0 / (K * D)) ** 0.5
    return {
        "x": _w((lambda *s: torch.randn(*s, dtype=torch.bfloat16) * 0.05)(B, T, D)),
        "w": _w((lambda *s: torch.randn(*s, dtype=torch.bfloat16) * 0.05)(K, D, D) * scale),
        "b": _w((lambda *s: torch.randn(*s, dtype=torch.bfloat16) * 0.05)(D) * 0.1),
        "gamma": _w(torch.ones((D,), dtype=float)),
        "beta": _w(torch.zeros((D,), dtype=float)),
    }

def reference(x, w, b, gamma, beta):
    B, T, D = x.shape
    K = w.shape[0]
    s = 2
    L = (T - K) // s + 1
    y = torch.einsum('blc,cd->bld', x[:, 0 : s * L : s, :], w[0])
    for i in range(1, K):
        y = y + torch.einsum('blc,cd->bld', x[:, i : i + s * L : s, :], w[i])
    y = y + b[None, None, :]
    mu = y.mean(1, keepdims=True)
    var = ((y - mu) ** 2).mean(1, keepdims=True)
    yn = (y - mu) / torch.sqrt(var + 1e-5)
    yn = yn * gamma[None, None, :] + beta[None, None, :]
    return _gelu(yn)
```

```asm
; @launch grid=(256,1,1) block=(512,1,1) lds=149504
.amdgcn_target "amdgcn-amd-amdhsa--gfx950"
.text
.globl standalone__self_sup_conv_stem_hubert__speech_kernel
.p2align 12
.p2align 8
.type standalone__self_sup_conv_stem_hubert__speech_kernel,@function
standalone__self_sup_conv_stem_hubert__speech_kernel:
L_start:
    s_load_dwordx16 s[4:19], s[0:1], 0
    s_getpc_b64 s[36:37]
L_pc:
    v_lshrrev_b32 v1, 6, v0
    v_bfe_u32 v5, v0, 3, 3
    v_readfirstlane_b32 s3, v1
    s_cmp_ge_u32 s2, 256
    s_cbranch_scc1 L_end
    v_and_b32 v0, 63, v0
    s_xor_b32 s3, s3, 4
    s_cmp_lg_u32 s3, 7
    s_cbranch_scc1 L_ncp
    s_bfe_u32 s40, s2, 0x20003
    v_lshl_add_u32 v199, v0, 2, s40
    v_lshlrev_b32 v199, 7, v199
    v_add_u32 v199, 960, v199
    v_min_u32 v199, L_codeend-L_pc-4, v199
    s_mov_b64 exec, 0x3fff
    global_load_dword v198, v199, s[36:37]
    s_mov_b64 exec, -1
L_ncp:
    s_and_b32 s44, s2, 1
    s_bfe_u32 s43, s2, 0x30001
    s_lshr_b32 s45, s2, 4
    s_add_u32 s34, s45, s43
    s_and_b32 s34, s34, 7
    v_and_b32 v6, 6, v5
    v_bitop3_b32 v6, v0, v6, 7 bitop3:0x28
    v_lshlrev_b32 v6, 4, v6
    v_lshl_add_u32 v2, v5, 14, v6
    v_and_b32 v7, 4, v5
    v_add_u32 v7, v7, v5
    v_lshl_add_u32 v3, v7, 10, v6
    s_mul_i32 s38, s44, 4096000
    s_add_u32 s22, s38, 4096000
    s_lshl_b32 s39, s45, 18
    s_add_u32 s38, s38, s39
    s_mov_b32 s23, 0x20000
    s_mov_b32 s26, 2621440
    s_mov_b32 s27, 0x20000
    s_mov_b32 s35, 0
    s_lshl_b32 s40, s3, 11
    s_add_u32 s47, s38, s35
    s_add_u32 s47, s47, s40
    s_lshl_b32 s48, s3, 12
    s_add_u32 m0, s48, 0
    s_and_b32 s49, s3, 6
    s_add_u32 s49, s49, s3
    s_lshl_b32 s49, s49, 12
    s_lshl_b32 s50, s35, 9
    s_add_u32 s49, s49, s50
    s_lshl_b32 s51, s43, 7
    s_add_u32 s49, s49, s51
    s_add_u32 s50, s47, 131072
    s_lshl_b32 s52, s3, 10
    s_lshl3_add_u32 s46, s44, s43
    s_lshl_b32 s39, s46, 7
    s_lshl_b32 s42, s43, 15
    s_add_u32 s42, s42, s38
    s_waitcnt lgkmcnt(0)
    s_mov_b32 s20, s4
    s_mov_b32 s21, s5
    s_mov_b32 s24, s6
    s_mov_b32 s25, s7
    buffer_load_dwordx4 v2, s[20:23], s47 offen  lds
    s_addk_i32 m0, 1024
    s_nop 0
    buffer_load_dwordx4 v2, s[20:23], s50 offen  lds
    s_add_u32 m0, s52, 33792
    s_cmp_lt_u32 s3, 4
    buffer_load_dwordx4 v3, s[24:27], s49 offen  lds
    s_cbranch_scc1 L_loader
    s_sub_u32 s48, s3, 4
    s_lshl_b32 s49, s48, 2
    s_lshr_b32 s49, 0x3142, s49
    s_and_b32 s49, s49, 7
    s_lshl_b32 s49, s49, 19
    s_lshl_b32 s50, s45, 12
    s_add_u32 s49, s49, s50
    s_add_u32 s49, s49, s51
    v_lshlrev_b32 v8, 10, v0
    s_mov_b64 exec, 0xf
    buffer_load_dword v198, v8, s[24:27], s49 offen
    s_mov_b64 exec, 0xf
    v_lshl_add_u32 v8, s48, 2, v0
    v_lshlrev_b32 v8, 11, v8
    buffer_load_dword v198, v8, s[20:23], s42 offen offset:1024
    s_mov_b64 exec, -1
    s_branch L_consumer
L_loader:
    v_lshrrev_b32 v7, 4, v0
    v_lshlrev_b32 v7, 11, v7
    v_and_b32 v4, 7, v0
    v_lshl_add_u32 v4, v4, 4, v7
    s_mov_b32 s33, 0x37654210
    s_lshl_b32 s57, s34, 2
    s_mov_b32 s47, s33
    s_lshr_b32 s58, 0x6543000, s57
    s_and_b32 s58, s58, 7
    s_lshl_b32 s58, s58, 2
    s_lshr_b32 s59, 0x41316310, s58
    s_and_b32 s59, s59, 7
    s_lshl_b32 s59, s59, s58
    s_lshr_b32 s58, s59, 4
    s_xor_b32 s33, s33, s59
    s_xor_b32 s33, s33, s58
    s_lshr_b32 s58, 0x6543200, s57
    s_and_b32 s58, s58, 7
    s_lshl_b32 s58, s58, 2
    s_lshr_b32 s59, 0x41316310, s58
    s_and_b32 s59, s59, 7
    s_lshl_b32 s59, s59, s58
    s_lshr_b32 s58, s59, 4
    s_xor_b32 s47, s47, s59
    s_xor_b32 s47, s47, s58
    s_add_u32 s34, s38, s40
    s_lshl_b32 s35, s3, 14
    s_add_u32 s35, s35, s51
    s_mov_b32 s52, s48
    s_add_u32 s54, s40, 33792
    s_mov_b32 s53, 74752
    s_and_b32 s59, s33, 7
    s_lshr_b32 s33, s33, 4
    s_lshl_b32 s48, s59, 7
    s_add_u32 s48, s48, s34
    s_lshl_b32 s49, s59, 16
    s_add_u32 s49, s49, s35
    s_and_b32 s59, s47, 7
    s_lshr_b32 s47, s47, 4
    s_lshl_b32 s94, s59, 7
    s_add_u32 s94, s94, s34
    s_lshl_b32 s95, s59, 16
    s_add_u32 s95, s95, s35
    s_cmp_lg_u32 s3, 0
    s_cbranch_scc1 L_x_1
    s_mov_b64 exec, 0x00ff00ff
    s_add_u32 m0, s52, 32768
    s_add_u32 s59, s48, 262144
    buffer_load_dwordx4 v4, s[20:23], s59 offen  lds
    s_mov_b64 exec, -1
L_x_1:
    s_add_u32 m0, s54, 16384
    s_add_u32 s59, s49, 1048576
    buffer_load_dwordx4 v3, s[24:27], s59 offen  lds
    s_addk_i32 m0, 1024
    s_addk_i32 s59, 4096
    buffer_load_dwordx4 v3, s[24:27], s59 offen  lds
    s_lshl2_add_u32 s41, s2, s3
    s_mul_i32 s41, s41, 5
    s_lshr_b32 s59, s41, 10
    s_and_b32 s41, s41, 1023
    s_lshl_b32 s41, s41, 6
    s_lshl_b32 s59, s59, 19
    s_add_u32 s41, s41, s59
    s_buffer_load_dword s92, s[24:27], s41 offset:65536
    s_buffer_load_dword s92, s[24:27], s41 offset:65600
    s_buffer_load_dword s92, s[24:27], s41 offset:65664
    s_buffer_load_dword s92, s[24:27], s41 offset:65728
    s_buffer_load_dword s92, s[24:27], s41 offset:65792
    s_add_u32 m0, s54, 32768
    s_add_u32 s59, s49, 2097152
    buffer_load_dwordx4 v3, s[24:27], s59 offen  lds
    s_addk_i32 m0, 1024
    s_addk_i32 s59, 4096
    buffer_load_dwordx4 v3, s[24:27], s59 offen  lds
    s_cmp_lg_u32 s3, 0
    s_cbranch_scc1 L_x_2
    s_mov_b64 exec, 0xff
    s_add_u32 m0, s52, 33280
    s_add_u32 s59, s94, 263168
    buffer_load_dwordx4 v4, s[20:23], s59 offen  lds
    s_mov_b64 exec, -1
L_x_2:
    s_add_u32 m0, s52, 2048
    s_add_u32 s59, s94, 1024
    buffer_load_dwordx4 v2, s[20:23], s59 offen  lds
    s_addk_i32 m0, 1024
    s_add_u32 s59, s59, 131072
    buffer_load_dwordx4 v2, s[20:23], s59 offen  lds
    s_add_u32 m0, s52, 18432
    s_add_u32 s59, s94, 9216
    buffer_load_dwordx4 v2, s[20:23], s59 offen  lds
    s_addk_i32 m0, 1024
    s_add_u32 s59, s59, 131072
    buffer_load_dwordx4 v2, s[20:23], s59 offen  lds
    s_add_u32 m0, s54, 8192
    s_add_u32 s59, s95, 524288
    buffer_load_dwordx4 v3, s[24:27], s59 offen  lds
    s_addk_i32 m0, 1024
    s_addk_i32 s59, 4096
    buffer_load_dwordx4 v3, s[24:27], s59 offen  lds
    s_waitcnt vmcnt(10)
    s_barrier
    s_add_u32 m0, s54, 24576
    s_add_u32 s59, s95, 1572864
    buffer_load_dwordx4 v3, s[24:27], s59 offen  lds
    s_addk_i32 m0, 1024
    s_addk_i32 s59, 4096
    buffer_load_dwordx4 v3, s[24:27], s59 offen  lds
    s_mov_b32 s50, 0x376542
    s_and_b32 s59, s50, 7
    s_lshr_b32 s50, s50, 4
    s_lshl_b32 s56, s59, 16
    s_add_u32 s56, s56, s41
    s_buffer_load_dword s92, s[24:27], s56 offset:0
    s_buffer_load_dword s92, s[24:27], s56 offset:64
    s_buffer_load_dword s92, s[24:27], s56 offset:128
    s_buffer_load_dword s92, s[24:27], s56 offset:192
    s_buffer_load_dword s92, s[24:27], s56 offset:256
    s_lshl_b32 s55, s3, 13
    s_add_u32 s55, s55, s42
    s_add_u32 s42, s55, 6144
    s_sub_u32 s55, s55, 2048
    s_add_u32 s52, s52, s53
    s_add_u32 s54, s54, s53
    s_sub_u32 s53, 0, s53
    s_addk_i32 s55, 2048
    s_min_u32 s55, s55, s42
    s_and_b32 s59, s50, 7
    s_lshr_b32 s50, s50, 4
    s_lshl_b32 s56, s59, 16
    s_add_u32 s56, s56, s41
    s_and_b32 s59, s33, 7
    s_lshr_b32 s33, s33, 4
    s_lshl_b32 s48, s59, 7
    s_add_u32 s48, s48, s34
    s_lshl_b32 s49, s59, 16
    s_add_u32 s49, s49, s35
    s_and_b32 s59, s47, 7
    s_lshr_b32 s47, s47, 4
    s_lshl_b32 s94, s59, 7
    s_add_u32 s94, s94, s34
    s_lshl_b32 s95, s59, 16
    s_add_u32 s95, s95, s35
    s_load_dword s32, s[18:19], s39 offset:262144
    s_waitcnt vmcnt(10)
    s_barrier
    s_mov_b32 s58, 1
    s_add_u32 m0, s54, 0
    s_add_u32 s59, s49, 0
    buffer_load_dwordx4 v3, s[24:27], s59 offen  lds
    s_addk_i32 m0, 1024
    s_addk_i32 s59, 4096
    buffer_load_dwordx4 v3, s[24:27], s59 offen  lds
    s_add_u32 m0, s54, 16384
    s_add_u32 s59, s49, 1048576
    buffer_load_dwordx4 v3, s[24:27], s59 offen  lds
    s_addk_i32 m0, 1024
    s_addk_i32 s59, 4096
    buffer_load_dwordx4 v3, s[24:27], s59 offen  lds
    s_buffer_load_dword s92, s[24:27], s56 offset:0
    s_waitcnt vmcnt(12)
    s_barrier
    s_branch L_lmid
L_lloop:
    s_add_u32 m0, s54, 0
    s_add_u32 s59, s49, 0
    buffer_load_dwordx4 v3, s[24:27], s59 offen  lds
    s_addk_i32 m0, 1024
    s_addk_i32 s59, 4096
    buffer_load_dwordx4 v3, s[24:27], s59 offen  lds
    s_waitcnt vmcnt(10)
    s_barrier
    s_add_u32 m0, s54, 16384
    s_add_u32 s59, s49, 1048576
    buffer_load_dwordx4 v3, s[24:27], s59 offen  lds
    s_addk_i32 m0, 1024
    s_addk_i32 s59, 4096
    buffer_load_dwordx4 v3, s[24:27], s59 offen  lds
    s_buffer_load_dword s92, s[24:27], s56 offset:0
L_lmid:
    s_add_u32 m0, s54, 32768
    s_add_u32 s59, s49, 2097152
    buffer_load_dwordx4 v3, s[24:27], s59 offen  lds
    s_addk_i32 m0, 1024
    s_addk_i32 s59, 4096
    buffer_load_dwordx4 v3, s[24:27], s59 offen  lds
    s_buffer_load_dword s92, s[24:27], s56 offset:64
    s_cmp_lg_u32 s3, 0
    s_cbranch_scc1 L_x_19
    s_mov_b64 exec, 0x00ff00ff
    s_add_u32 m0, s52, 32768
    s_add_u32 s59, s48, 262144
    buffer_load_dwordx4 v4, s[20:23], s59 offen  lds
    s_mov_b64 exec, -1
L_x_19:
    s_add_u32 m0, s52, 0
    s_add_u32 s59, s48, 0
    buffer_load_dwordx4 v2, s[20:23], s59 offen  lds
    s_addk_i32 m0, 1024
    s_add_u32 s59, s59, 131072
    buffer_load_dwordx4 v2, s[20:23], s59 offen  lds
    s_buffer_load_dwordx2 s[92:93], s[20:23], s55 offset:444
    s_add_u32 m0, s52, 16384
    s_add_u32 s59, s48, 8192
    buffer_load_dwordx4 v2, s[20:23], s59 offen  lds
    s_addk_i32 m0, 1024
    s_add_u32 s59, s59, 131072
    buffer_load_dwordx4 v2, s[20:23], s59 offen  lds
    s_cmp_lg_u32 s3, 0
    s_cbranch_scc1 L_x_20
    s_mov_b64 exec, 0xff
    s_add_u32 m0, s52, 33280
    s_add_u32 s59, s94, 263168
    buffer_load_dwordx4 v4, s[20:23], s59 offen  lds
    s_mov_b64 exec, -1
L_x_20:
    s_add_u32 m0, s52, 2048
    s_add_u32 s59, s94, 1024
    buffer_load_dwordx4 v2, s[20:23], s59 offen  lds
    s_waitcnt vmcnt(11)
    s_barrier
    s_addk_i32 m0, 1024
    s_add_u32 s59, s59, 131072
    buffer_load_dwordx4 v2, s[20:23], s59 offen  lds
    s_buffer_load_dword s92, s[24:27], s56 offset:128
    s_add_u32 m0, s52, 18432
    s_add_u32 s59, s94, 9216
    buffer_load_dwordx4 v2, s[20:23], s59 offen  lds
    s_addk_i32 m0, 1024
    s_add_u32 s59, s59, 131072
    buffer_load_dwordx4 v2, s[20:23], s59 offen  lds
    s_buffer_load_dword s92, s[24:27], s56 offset:192
    s_add_u32 m0, s54, 8192
    s_add_u32 s59, s95, 524288
    buffer_load_dwordx4 v3, s[24:27], s59 offen  lds
    s_addk_i32 m0, 1024
    s_addk_i32 s59, 4096
    buffer_load_dwordx4 v3, s[24:27], s59 offen  lds
    s_buffer_load_dwordx2 s[92:93], s[20:23], s55 offset:1468
    s_add_u32 m0, s54, 24576
    s_add_u32 s59, s95, 1572864
    buffer_load_dwordx4 v3, s[24:27], s59 offen  lds
    s_addk_i32 m0, 1024
    s_addk_i32 s59, 4096
    buffer_load_dwordx4 v3, s[24:27], s59 offen  lds
    s_buffer_load_dword s92, s[24:27], s56 offset:256
    s_add_u32 s52, s52, s53
    s_add_u32 s54, s54, s53
    s_sub_u32 s53, 0, s53
    s_addk_i32 s55, 2048
    s_min_u32 s55, s55, s42
    s_and_b32 s59, s50, 7
    s_lshr_b32 s50, s50, 4
    s_lshl_b32 s56, s59, 16
    s_add_u32 s56, s56, s41
    s_and_b32 s59, s33, 7
    s_lshr_b32 s33, s33, 4
    s_lshl_b32 s48, s59, 7
    s_add_u32 s48, s48, s34
    s_lshl_b32 s49, s59, 16
    s_add_u32 s49, s49, s35
    s_and_b32 s59, s47, 7
    s_lshr_b32 s47, s47, 4
    s_lshl_b32 s94, s59, 7
    s_add_u32 s94, s94, s34
    s_lshl_b32 s95, s59, 16
    s_add_u32 s95, s95, s35
    s_add_u32 s58, s58, 1
    s_cmp_le_u32 s58, 7
    s_cbranch_scc1 L_lloop
    s_waitcnt vmcnt(8)
    s_barrier
    s_waitcnt vmcnt(0)
    s_barrier
    s_lshl_b32 s58, s46, 14
    s_lshl_b32 s59, s3, 12
    s_add_u32 s58, s58, s59
    s_add_u32 s58, s58, 524288
    v_lshl_add_u32 v13, v0, 4, s58
    global_load_dwordx4 v[20:23], v13, s[18:19] offset:0 sc1
    global_load_dwordx4 v[24:27], v13, s[18:19] offset:1024 sc1
    global_load_dwordx4 v[28:31], v13, s[18:19] offset:2048 sc1
    global_load_dwordx4 v[32:35], v13, s[18:19] offset:3072 sc1
    v_and_b32 v10, 15, v0
    s_lshl_b32 s58, s43, 6
    s_lshl4_add_u32 s58, s3, s58
    v_add_lshl_u32 v11, v10, s58, 1
    global_load_short_d16_hi v15, v11, s[8:9]
    global_load_short_d16_hi v16, v11, s[10:11]
    global_load_short_d16_hi v17, v11, s[12:13]
    s_lshl_b32 s58, s3, 6
    s_add_u32 s58, s58, 65536
    v_lshl_add_u32 v10, v10, 2, s58
    s_waitcnt lgkmcnt(0)
    s_mul_i32 s32, s32, 1664525
    s_add_u32 s32, s32, 1013904223
    v_mov_b32 v12, s32
    ds_write_b32 v10, v12 offset:512
    s_mov_b32 s33, s32
    s_mov_b32 s58, 0
    s_mov_b32 s59, 0x3a033405
    s_waitcnt lgkmcnt(0)
    s_barrier
    s_waitcnt vmcnt(0)
    v_and_b32 v15, 0xffff0000, v15
    v_and_b32 v16, 0xffff0000, v16
    v_and_b32 v17, 0xffff0000, v17
    s_branch L_pchk
L_ps:
    s_cmp_ge_u32 s58, 32
    s_cbranch_scc1 L_fb
L_fbr:
    s_mov_b64 exec, s[64:65]
    s_cbranch_execz L_pk0
    global_load_dwordx4 v[20:23], v13, s[18:19] offset:0 sc1
L_pk0:
    s_mov_b64 exec, s[66:67]
    s_cbranch_execz L_pk1
    global_load_dwordx4 v[24:27], v13, s[18:19] offset:1024 sc1
L_pk1:
    s_mov_b64 exec, s[68:69]
    s_cbranch_execz L_pk2
    global_load_dwordx4 v[28:31], v13, s[18:19] offset:2048 sc1
L_pk2:
    s_mov_b64 exec, s[70:71]
    s_cbranch_execz L_pk3
    global_load_dwordx4 v[32:35], v13, s[18:19] offset:3072 sc1
L_pk3:
    s_add_u32 s58, s58, 1
L_pchk:
    s_mov_b64 exec, -1
    s_waitcnt vmcnt(0)
    v_xor_b32 v56, v20, v21
    v_xor_b32 v57, v22, v23
    v_xor_b32 v58, v24, v25
    v_xor_b32 v59, v26, v27
    v_xor_b32 v60, v28, v29
    v_xor_b32 v61, v30, v31
    v_xor_b32 v62, v32, v33
    v_xor_b32 v63, v34, v35
    v_cmp_ne_u64 s[64:65], s[32:33], v[56:57]
    v_cmp_ne_u64 s[66:67], s[32:33], v[58:59]
    v_cmp_ne_u64 s[68:69], s[32:33], v[60:61]
    v_cmp_ne_u64 s[70:71], s[32:33], v[62:63]
    s_or_b64 s[72:73], s[64:65], s[66:67]
    s_or_b64 s[74:75], s[68:69], s[70:71]
    s_or_b64 s[76:77], s[72:73], s[74:75]
    s_cbranch_scc1 L_ps
L_ps_ok:
    v_add_f32 v36, v20, v24
    v_add_f32 v37, v22, v26
    v_add_f32 v38, v28, v32
    v_add_f32 v39, v30, v34
    v_add_f32 v20, v36, v38
    v_add_f32 v21, v37, v39
    s_nop 1
    v_permlane32_swap_b32 v20, v21
    v_add_f32 v22, v20, v21
    v_add_f32 v20, v20, v21
    s_nop 1
    v_permlane16_swap_b32 v20, v22
    v_add_f32 v20, v20, v22
    v_mul_f32 v21, s59, v20
    v_mul_f32 v20, s59, v20
    s_nop 1
    v_permlane32_swap_b32 v20, v21
    v_fma_f32 v21, -v20, v20, v21
    v_add_f32 v20, v20, v15
    v_max_f32 v21, 0, v21
    v_add_f32 v21, 0x3727c5ac, v21
    v_rsq_f32 v21, v21
    v_sub_f32 v20, v15, v20
    v_mul_f32 v21, v21, v16
    v_fma_f32 v20, v20, v21, v17
    ds_write2_b32 v10, v21, v20 offset0:0 offset1:64
    s_waitcnt lgkmcnt(0)
    s_barrier
    s_or_b32 s58, s3, s45
    s_cselect_b64 s[54:55], 0, 1
    s_add_u32 s58, s39, 262144
    v_mov_b32 v1, s58
    v_mov_b32 v12, s32
    s_lshl_b32 s58, s3, 12
    s_and_b32 s59, s3, 2
    s_lshl_b32 s59, s59, 5
    v_lshl_add_u32 v4, v0, 4, s58
    v_xor_b32 v4, s59, v4
    v_and_b32 v3, 15, v0
    v_lshlrev_b32 v5, 4, v3
    v_add_u32 v5, 0x10000, v5
    s_mul_i32 s58, s44, 2045952
    s_add_u32 s30, s58, 2045952
    s_mov_b32 s31, 0x20000
    s_mov_b32 s28, s14
    s_mov_b32 s29, s15
    s_lshl_b32 s59, s45, 17
    s_add_u32 s58, s58, s59
    s_add_u32 s58, s58, s51
    s_lshl_b32 s59, s3, 14
    s_add_u32 s40, s58, s59
    s_add_u32 s41, s40, 0x1000
    s_add_u32 s42, s40, 0x2000
    s_add_u32 s43, s40, 0x3000
    v_lshrrev_b32 v2, 4, v0
    v_lshlrev_b32 v6, 10, v2
    v_lshl_add_u32 v6, v3, 3, v6
    s_mov_b32 s52, 0xbdd2d3e8
    s_mov_b32 s53, 0xc0135761
    ds_read_b128 v[16:19], v5
    ds_read_b128 v[24:27], v5 offset:256
    ds_read_b128 v[40:43], v4 offset:32768
    ds_read_b128 v[44:47], v4 offset:33792
    ds_read_b128 v[48:51], v4 offset:34816
    ds_read_b128 v[52:55], v4 offset:35840
    s_branch L_final
L_consumer:
    s_and_b32 s49, s48, 1
    v_and_b32 v8, 15, v0
    v_lshrrev_b32 v9, 4, v0
    v_lshl_add_u32 v10, s49, 2, v9
    v_and_b32 v11, 6, v8
    v_xor_b32 v11, v11, v10
    v_lshlrev_b32 v11, 4, v11
    v_lshl_add_u32 v2, v8, 7, v11
    v_add_u32 v14, 1, v8
    v_and_b32 v11, 6, v14
    v_xor_b32 v11, v11, v10
    v_lshlrev_b32 v11, 4, v11
    v_lshl_add_u32 v3, v14, 7, v11
    v_cmp_eq_u32 vcc, 15, v8
    v_mov_b32 v11, 2048
    v_mov_b32 v12, 31232
    v_cndmask_b32 v11, v11, v12, vcc
    v_add_u32 v4, v3, v11
    v_mov_b32 v11, 4096
    v_mov_b32 v12, 30976
    v_cndmask_b32 v11, v11, v12, vcc
    v_add_u32 v5, v3, v11
    v_mov_b32 v12, 30720
    v_cndmask_b32 v11, 0, v12, vcc
    v_add_u32 v3, v3, v11
    v_bfe_u32 v11, v0, 2, 3
    v_lshrrev_b32 v12, 5, v0
    v_lshl_add_u32 v12, s49, 1, v12
    v_lshlrev_b32 v12, 11, v12
    v_lshl_add_u32 v12, v11, 7, v12
    v_bfe_u32 v14, v0, 1, 1
    v_lshl_add_u32 v14, s48, 1, v14
    v_and_b32 v11, 6, v11
    v_xor_b32 v14, v14, v11
    v_lshl_add_u32 v12, v14, 4, v12
    v_and_b32 v14, 1, v0
    v_lshl_add_u32 v12, v14, 3, v12
    v_add_u32 v7, 33792, v12
    v_xor_b32 v6, 32, v7
    s_mov_b32 s53, 74752
    s_mov_b32 s55, 74752
    s_lshl_b32 s50, s48, 13
    v_lshl_add_u32 v10, v0, 3, s50
    v_xor_b32 v11, 0x2000, v10
    s_lshl_b32 s54, s46, 14
    s_lshl_b32 s56, s45, 8
    s_add_u32 s54, s54, s56
    s_lshl_b32 s56, s48, 12
    s_add_u32 s54, s54, s56
    v_lshl_add_u32 v14, v8, 4, s54
    v_lshrrev_b32 v12, 5, v0
    v_lshl_add_u32 v14, v12, 3, v14
    v_add_u32 v1, 524288, v14
    s_cmp_eq_u32 s45, 15
    s_cselect_b32 s35, 0xffff, 0
    s_mov_b32 s34, 0
    s_lshl_b32 s54, s48, 6
    s_add_u32 s54, s54, 32768
    v_lshlrev_b32 v15, 13, v9
    v_lshl_add_u32 v15, v8, 2, v15
    v_add_u32 v15, s54, v15
    v_mov_b32 v12, 0x10200
    s_mov_b32 s57, 7
    v_and_b32 v14, 16, v0
    v_lshlrev_b32 v14, 2, v14
    v_xor_b32 v15, v14, v15
    v_xor_b32 v14, 16, v15
    s_branch L_cpage
    .p2align 12
L_cpage:
    s_waitcnt vmcnt(0) lgkmcnt(0)
    s_barrier
    ds_read_b128 v[16:19], v2 offset:0
    ds_read_b64_tr_b16 v[92:93], v6 offset:0
    ds_read_b64_tr_b16 v[94:95], v6 offset:1024
    ds_read_b64_tr_b16 v[96:97], v7 offset:0
    ds_read_b64_tr_b16 v[98:99], v7 offset:1024
    ds_read_b128 v[24:27], v2 offset:4096
    ds_read_b128 v[32:35], v2 offset:8192
    ds_read_b128 v[40:43], v2 offset:12288
    ds_read_b128 v[48:51], v2 offset:16384
    ds_read_b128 v[56:59], v2 offset:20480
    ds_read_b128 v[64:67], v2 offset:24576
    ds_read_b128 v[72:75], v2 offset:28672
    s_waitcnt lgkmcnt(9)
    v_mfma_f32_16x16x32_bf16 v[132:135], v[16:19], v[92:95], 0
    s_waitcnt lgkmcnt(7)
    v_mfma_f32_16x16x32_bf16 v[164:167], v[16:19], v[96:99], 0
    s_waitcnt lgkmcnt(6)
    v_mfma_f32_16x16x32_bf16 v[136:139], v[24:27], v[92:95], 0
    v_mfma_f32_16x16x32_bf16 v[168:171], v[24:27], v[96:99], 0
    s_waitcnt lgkmcnt(5)
    v_mfma_f32_16x16x32_bf16 v[140:143], v[32:35], v[92:95], 0
    s_barrier
    ds_read_b64_tr_b16 v[108:109], v6 offset:16384
    ds_read_b64_tr_b16 v[110:111], v6 offset:17408
    v_mfma_f32_16x16x32_bf16 v[172:175], v[32:35], v[96:99], 0
    ds_read_b64_tr_b16 v[112:113], v7 offset:16384
    ds_read_b64_tr_b16 v[114:115], v7 offset:17408
    s_waitcnt lgkmcnt(8)
    v_mfma_f32_16x16x32_bf16 v[144:147], v[40:43], v[92:95], 0
    ds_read_b128 v[80:83], v3
    ds_read_b128 v[88:91], v5
    v_mfma_f32_16x16x32_bf16 v[176:179], v[40:43], v[96:99], 0
    s_waitcnt lgkmcnt(6)
    v_mfma_f32_16x16x32_bf16 v[148:151], v[48:51], v[92:95], 0
    v_mfma_f32_16x16x32_bf16 v[180:183], v[48:51], v[96:99], 0
    v_mfma_f32_16x16x32_bf16 v[152:155], v[56:59], v[92:95], 0
    v_mfma_f32_16x16x32_bf16 v[184:187], v[56:59], v[96:99], 0
    v_mfma_f32_16x16x32_bf16 v[156:159], v[64:67], v[92:95], 0
    v_mfma_f32_16x16x32_bf16 v[188:191], v[64:67], v[96:99], 0
    v_mfma_f32_16x16x32_bf16 v[160:163], v[72:75], v[92:95], 0
    v_mfma_f32_16x16x32_bf16 v[192:195], v[72:75], v[96:99], 0
    s_waitcnt lgkmcnt(0)
    v_mfma_f32_16x16x32_bf16 v[132:135], v[24:27], v[108:111], v[132:135]
    v_mfma_f32_16x16x32_bf16 v[164:167], v[24:27], v[112:115], v[164:167]
    v_mfma_f32_16x16x32_bf16 v[136:139], v[32:35], v[108:111], v[136:139]
    v_mfma_f32_16x16x32_bf16 v[168:171], v[32:35], v[112:115], v[168:171]
    v_mfma_f32_16x16x32_bf16 v[140:143], v[40:43], v[108:111], v[140:143]
    s_barrier
    ds_read_b64_tr_b16 v[124:125], v6 offset:32768
    ds_read_b64_tr_b16 v[126:127], v6 offset:33792
    v_mfma_f32_16x16x32_bf16 v[172:175], v[40:43], v[112:115], v[172:175]
    ds_read_b64_tr_b16 v[128:129], v7 offset:32768
    ds_read_b64_tr_b16 v[130:131], v7 offset:33792
    v_mfma_f32_16x16x32_bf16 v[144:147], v[48:51], v[108:111], v[144:147]
    v_mfma_f32_16x16x32_bf16 v[176:179], v[48:51], v[112:115], v[176:179]
    v_mfma_f32_16x16x32_bf16 v[148:151], v[56:59], v[108:111], v[148:151]
    v_mfma_f32_16x16x32_bf16 v[180:183], v[56:59], v[112:115], v[180:183]
    v_mfma_f32_16x16x32_bf16 v[152:155], v[64:67], v[108:111], v[152:155]
    v_mfma_f32_16x16x32_bf16 v[184:187], v[64:67], v[112:115], v[184:187]
    v_mfma_f32_16x16x32_bf16 v[156:159], v[72:75], v[108:111], v[156:159]
    v_mfma_f32_16x16x32_bf16 v[188:191], v[72:75], v[112:115], v[188:191]
    v_mfma_f32_16x16x32_bf16 v[160:163], v[80:83], v[108:111], v[160:163]
    v_mfma_f32_16x16x32_bf16 v[192:195], v[80:83], v[112:115], v[192:195]
    s_waitcnt lgkmcnt(0)
    v_mfma_f32_16x16x32_bf16 v[132:135], v[32:35], v[124:127], v[132:135]
    v_mfma_f32_16x16x32_bf16 v[164:167], v[32:35], v[128:131], v[164:167]
    v_mfma_f32_16x16x32_bf16 v[136:139], v[40:43], v[124:127], v[136:139]
    v_mfma_f32_16x16x32_bf16 v[168:171], v[40:43], v[128:131], v[168:171]
    v_mfma_f32_16x16x32_bf16 v[140:143], v[48:51], v[124:127], v[140:143]
    s_barrier
    ds_read_b128 v[20:23], v2 offset:2048
    ds_read_b64_tr_b16 v[100:101], v6 offset:8192
    v_mfma_f32_16x16x32_bf16 v[172:175], v[48:51], v[128:131], v[172:175]
    ds_read_b64_tr_b16 v[102:103], v6 offset:9216
    ds_read_b128 v[28:31], v2 offset:6144
    v_mfma_f32_16x16x32_bf16 v[144:147], v[56:59], v[124:127], v[144:147]
    ds_read_b64_tr_b16 v[116:117], v6 offset:24576
    ds_read_b64_tr_b16 v[118:119], v6 offset:25600
    v_mfma_f32_16x16x32_bf16 v[176:179], v[56:59], v[128:131], v[176:179]
    ds_read_b128 v[36:39], v2 offset:10240
    ds_read_b128 v[44:47], v2 offset:14336
    v_mfma_f32_16x16x32_bf16 v[148:151], v[64:67], v[124:127], v[148:151]
    ds_read_b128 v[52:55], v2 offset:18432
    ds_read_b128 v[60:63], v2 offset:22528
    v_mfma_f32_16x16x32_bf16 v[180:183], v[64:67], v[128:131], v[180:183]
    ds_read_b128 v[68:71], v2 offset:26624
    ds_read_b128 v[76:79], v2 offset:30720
    v_mfma_f32_16x16x32_bf16 v[152:155], v[72:75], v[124:127], v[152:155]
    ds_read_b128 v[84:87], v4
    ds_read_b64_tr_b16 v[104:105], v7 offset:8192
    v_mfma_f32_16x16x32_bf16 v[184:187], v[72:75], v[128:131], v[184:187]
    ds_read_b64_tr_b16 v[106:107], v7 offset:9216
    ds_read_b64_tr_b16 v[120:121], v7 offset:24576
    v_mfma_f32_16x16x32_bf16 v[156:159], v[80:83], v[124:127], v[156:159]
    ds_read_b64_tr_b16 v[122:123], v7 offset:25600
    v_mfma_f32_16x16x32_bf16 v[188:191], v[80:83], v[128:131], v[188:191]
    v_mfma_f32_16x16x32_bf16 v[160:163], v[88:91], v[124:127], v[160:163]
    v_mfma_f32_16x16x32_bf16 v[192:195], v[88:91], v[128:131], v[192:195]
    .p2align 3
L_cloop:
    s_waitcnt lgkmcnt(4)
    v_mfma_f32_16x16x32_bf16 v[132:135], v[20:23], v[100:103], v[132:135]
    v_mfma_f32_16x16x32_bf16 v[132:135], v[28:31], v[116:119], v[132:135]
    v_add_u32 v2, s53, v2
    v_mfma_f32_16x16x32_bf16 v[136:139], v[36:39], v[116:119], v[136:139]
    v_add_u32 v3, s53, v3
    v_mfma_f32_16x16x32_bf16 v[136:139], v[28:31], v[100:103], v[136:139]
    v_add_u32 v4, s53, v4
    v_mfma_f32_16x16x32_bf16 v[140:143], v[36:39], v[100:103], v[140:143]
    v_add_u32 v5, s53, v5
    v_mfma_f32_16x16x32_bf16 v[140:143], v[44:47], v[116:119], v[140:143]
    s_sub_u32 s53, 0, s53
    v_mfma_f32_16x16x32_bf16 v[144:147], v[52:55], v[116:119], v[144:147]
    v_add_u32 v6, s55, v6
    v_mfma_f32_16x16x32_bf16 v[144:147], v[44:47], v[100:103], v[144:147]
    v_add_u32 v7, s55, v7
    v_mfma_f32_16x16x32_bf16 v[148:151], v[52:55], v[100:103], v[148:151]
    s_sub_u32 s55, 0, s55
    v_mfma_f32_16x16x32_bf16 v[148:151], v[60:63], v[116:119], v[148:151]
    s_sub_u32 s57, s57, 1
    s_waitcnt lgkmcnt(0)
    v_mfma_f32_16x16x32_bf16 v[152:155], v[68:71], v[116:119], v[152:155]
    s_cmp_lg_u32 s57, 0
    v_mfma_f32_16x16x32_bf16 v[152:155], v[60:63], v[100:103], v[152:155]
    v_mfma_f32_16x16x32_bf16 v[156:159], v[68:71], v[100:103], v[156:159]
    v_mfma_f32_16x16x32_bf16 v[156:159], v[76:79], v[116:119], v[156:159]
    v_mfma_f32_16x16x32_bf16 v[160:163], v[84:87], v[116:119], v[160:163]
    v_mfma_f32_16x16x32_bf16 v[160:163], v[76:79], v[100:103], v[160:163]
    s_waitcnt lgkmcnt(0)
    v_mfma_f32_16x16x32_bf16 v[164:167], v[20:23], v[104:107], v[164:167]
    v_mfma_f32_16x16x32_bf16 v[164:167], v[28:31], v[120:123], v[164:167]
    v_mfma_f32_16x16x32_bf16 v[168:171], v[36:39], v[120:123], v[168:171]
    v_mfma_f32_16x16x32_bf16 v[168:171], v[28:31], v[104:107], v[168:171]
    v_mfma_f32_16x16x32_bf16 v[172:175], v[36:39], v[104:107], v[172:175]
    s_barrier
    ds_read_b64_tr_b16 v[92:93], v6 offset:0
    v_mfma_f32_16x16x32_bf16 v[172:175], v[44:47], v[120:123], v[172:175]
    ds_read_b64_tr_b16 v[94:95], v6 offset:1024
    v_mfma_f32_16x16x32_bf16 v[176:179], v[52:55], v[120:123], v[176:179]
    ds_read_b128 v[16:19], v2 offset:0
    v_mfma_f32_16x16x32_bf16 v[176:179], v[44:47], v[104:107], v[176:179]
    ds_read_b64_tr_b16 v[108:109], v6 offset:16384
    v_mfma_f32_16x16x32_bf16 v[180:183], v[52:55], v[104:107], v[180:183]
    ds_read_b64_tr_b16 v[110:111], v6 offset:17408
    v_mfma_f32_16x16x32_bf16 v[180:183], v[60:63], v[120:123], v[180:183]
    ds_read_b128 v[24:27], v2 offset:4096
    v_mfma_f32_16x16x32_bf16 v[184:187], v[68:71], v[120:123], v[184:187]
    ds_read_b64_tr_b16 v[124:125], v6 offset:32768
    v_mfma_f32_16x16x32_bf16 v[184:187], v[60:63], v[104:107], v[184:187]
    ds_read_b64_tr_b16 v[126:127], v6 offset:33792
    v_mfma_f32_16x16x32_bf16 v[188:191], v[68:71], v[104:107], v[188:191]
    ds_read_b128 v[32:35], v2 offset:8192
    v_mfma_f32_16x16x32_bf16 v[188:191], v[76:79], v[120:123], v[188:191]
    ds_read_b128 v[40:43], v2 offset:12288
    v_mfma_f32_16x16x32_bf16 v[192:195], v[84:87], v[120:123], v[192:195]
    ds_read_b128 v[48:51], v2 offset:16384
    v_mfma_f32_16x16x32_bf16 v[192:195], v[76:79], v[104:107], v[192:195]
    ds_read_b128 v[56:59], v2 offset:20480
    s_waitcnt lgkmcnt(7)
    v_mfma_f32_16x16x32_bf16 v[132:135], v[16:19], v[92:95], v[132:135]
    ds_read_b128 v[64:67], v2 offset:24576
    s_waitcnt lgkmcnt(7)
    v_mfma_f32_16x16x32_bf16 v[132:135], v[24:27], v[108:111], v[132:135]
    ds_read_b128 v[72:75], v2 offset:28672
    s_waitcnt lgkmcnt(5)
    v_mfma_f32_16x16x32_bf16 v[132:135], v[32:35], v[124:127], v[132:135]
    ds_read_b128 v[80:83], v3
    s_waitcnt lgkmcnt(5)
    v_mfma_f32_16x16x32_bf16 v[136:139], v[40:43], v[124:127], v[136:139]
    ds_read_b128 v[88:91], v5
    v_mfma_f32_16x16x32_bf16 v[136:139], v[32:35], v[108:111], v[136:139]
    ds_read_b64_tr_b16 v[96:97], v7 offset:0
    v_mfma_f32_16x16x32_bf16 v[136:139], v[24:27], v[92:95], v[136:139]
    ds_read_b64_tr_b16 v[98:99], v7 offset:1024
    v_mfma_f32_16x16x32_bf16 v[140:143], v[32:35], v[92:95], v[140:143]
    ds_read_b64_tr_b16 v[112:113], v7 offset:16384
    v_mfma_f32_16x16x32_bf16 v[140:143], v[40:43], v[108:111], v[140:143]
    ds_read_b64_tr_b16 v[114:115], v7 offset:17408
    s_waitcnt lgkmcnt(7)
    v_mfma_f32_16x16x32_bf16 v[140:143], v[48:51], v[124:127], v[140:143]
    ds_read_b64_tr_b16 v[128:129], v7 offset:32768
    v_mfma_f32_16x16x32_bf16 v[144:147], v[56:59], v[124:127], v[144:147]
    ds_read_b64_tr_b16 v[130:131], v7 offset:33792
    v_mfma_f32_16x16x32_bf16 v[144:147], v[48:51], v[108:111], v[144:147]
    v_mfma_f32_16x16x32_bf16 v[144:147], v[40:43], v[92:95], v[144:147]
    v_mfma_f32_16x16x32_bf16 v[148:151], v[48:51], v[92:95], v[148:151]
    v_mfma_f32_16x16x32_bf16 v[148:151], v[56:59], v[108:111], v[148:151]
    v_mfma_f32_16x16x32_bf16 v[148:151], v[64:67], v[124:127], v[148:151]
    s_waitcnt lgkmcnt(2)
    v_mfma_f32_16x16x32_bf16 v[152:155], v[72:75], v[124:127], v[152:155]
    v_mfma_f32_16x16x32_bf16 v[152:155], v[64:67], v[108:111], v[152:155]
    v_mfma_f32_16x16x32_bf16 v[152:155], v[56:59], v[92:95], v[152:155]
    v_mfma_f32_16x16x32_bf16 v[156:159], v[64:67], v[92:95], v[156:159]
    v_mfma_f32_16x16x32_bf16 v[156:159], v[72:75], v[108:111], v[156:159]
    v_mfma_f32_16x16x32_bf16 v[156:159], v[80:83], v[124:127], v[156:159]
    v_mfma_f32_16x16x32_bf16 v[160:163], v[88:91], v[124:127], v[160:163]
    v_mfma_f32_16x16x32_bf16 v[160:163], v[80:83], v[108:111], v[160:163]
    v_mfma_f32_16x16x32_bf16 v[160:163], v[72:75], v[92:95], v[160:163]
    v_mfma_f32_16x16x32_bf16 v[164:167], v[16:19], v[96:99], v[164:167]
    v_mfma_f32_16x16x32_bf16 v[164:167], v[24:27], v[112:115], v[164:167]
    s_waitcnt lgkmcnt(0)
    v_mfma_f32_16x16x32_bf16 v[164:167], v[32:35], v[128:131], v[164:167]
    v_mfma_f32_16x16x32_bf16 v[168:171], v[40:43], v[128:131], v[168:171]
    s_cbranch_scc0 L_ctail
    v_mfma_f32_16x16x32_bf16 v[168:171], v[32:35], v[112:115], v[168:171]
    s_barrier
    ds_read_b64_tr_b16 v[100:101], v6 offset:8192
    v_mfma_f32_16x16x32_bf16 v[168:171], v[24:27], v[96:99], v[168:171]
    ds_read_b64_tr_b16 v[102:103], v6 offset:9216
    v_mfma_f32_16x16x32_bf16 v[172:175], v[32:35], v[96:99], v[172:175]
    ds_read_b128 v[20:23], v2 offset:2048
    v_mfma_f32_16x16x32_bf16 v[172:175], v[40:43], v[112:115], v[172:175]
    ds_read_b64_tr_b16 v[116:117], v6 offset:24576
    v_mfma_f32_16x16x32_bf16 v[172:175], v[48:51], v[128:131], v[172:175]
    ds_read_b64_tr_b16 v[118:119], v6 offset:25600
    v_mfma_f32_16x16x32_bf16 v[176:179], v[56:59], v[128:131], v[176:179]
    ds_read_b128 v[28:31], v2 offset:6144
    v_mfma_f32_16x16x32_bf16 v[176:179], v[48:51], v[112:115], v[176:179]
    ds_read_b128 v[36:39], v2 offset:10240
    v_mfma_f32_16x16x32_bf16 v[176:179], v[40:43], v[96:99], v[176:179]
    ds_read_b128 v[44:47], v2 offset:14336
    v_mfma_f32_16x16x32_bf16 v[180:183], v[48:51], v[96:99], v[180:183]
    ds_read_b128 v[52:55], v2 offset:18432
    v_mfma_f32_16x16x32_bf16 v[180:183], v[56:59], v[112:115], v[180:183]
    ds_read_b128 v[60:63], v2 offset:22528
    v_mfma_f32_16x16x32_bf16 v[180:183], v[64:67], v[128:131], v[180:183]
    ds_read_b128 v[68:71], v2 offset:26624
    v_mfma_f32_16x16x32_bf16 v[184:187], v[72:75], v[128:131], v[184:187]
    ds_read_b128 v[76:79], v2 offset:30720
    v_mfma_f32_16x16x32_bf16 v[184:187], v[64:67], v[112:115], v[184:187]
    ds_read_b128 v[84:87], v4
    v_mfma_f32_16x16x32_bf16 v[184:187], v[56:59], v[96:99], v[184:187]
    ds_read_b64_tr_b16 v[104:105], v7 offset:8192
    v_mfma_f32_16x16x32_bf16 v[188:191], v[64:67], v[96:99], v[188:191]
    ds_read_b64_tr_b16 v[106:107], v7 offset:9216
    v_mfma_f32_16x16x32_bf16 v[188:191], v[72:75], v[112:115], v[188:191]
    ds_read_b64_tr_b16 v[120:121], v7 offset:24576
    v_mfma_f32_16x16x32_bf16 v[188:191], v[80:83], v[128:131], v[188:191]
    ds_read_b64_tr_b16 v[122:123], v7 offset:25600
    v_mfma_f32_16x16x32_bf16 v[192:195], v[88:91], v[128:131], v[192:195]
    v_mfma_f32_16x16x32_bf16 v[192:195], v[80:83], v[112:115], v[192:195]
    v_mfma_f32_16x16x32_bf16 v[192:195], v[72:75], v[96:99], v[192:195]
    s_branch L_cloop
L_ctail:
    v_mfma_f32_16x16x32_bf16 v[168:171], v[32:35], v[112:115], v[168:171]
    s_barrier
    ds_read_b128 v[20:23], v2 offset:2048
    ds_read_b64_tr_b16 v[100:101], v6 offset:8192
    v_mfma_f32_16x16x32_bf16 v[168:171], v[24:27], v[96:99], v[168:171]
    ds_read_b64_tr_b16 v[102:103], v6 offset:9216
    ds_read_b128 v[28:31], v2 offset:6144
    v_mfma_f32_16x16x32_bf16 v[172:175], v[32:35], v[96:99], v[172:175]
    ds_read_b64_tr_b16 v[116:117], v6 offset:24576
    ds_read_b64_tr_b16 v[118:119], v6 offset:25600
    v_mfma_f32_16x16x32_bf16 v[172:175], v[40:43], v[112:115], v[172:175]
    ds_read_b128 v[36:39], v2 offset:10240
    ds_read_b128 v[44:47], v2 offset:14336
    v_mfma_f32_16x16x32_bf16 v[172:175], v[48:51], v[128:131], v[172:175]
    ds_read_b128 v[52:55], v2 offset:18432
    ds_read_b128 v[60:63], v2 offset:22528
    v_mfma_f32_16x16x32_bf16 v[176:179], v[56:59], v[128:131], v[176:179]
    ds_read_b128 v[68:71], v2 offset:26624
    ds_read_b128 v[76:79], v2 offset:30720
    v_mfma_f32_16x16x32_bf16 v[176:179], v[48:51], v[112:115], v[176:179]
    ds_read_b128 v[84:87], v4
    ds_read_b64_tr_b16 v[104:105], v7 offset:8192
    v_mfma_f32_16x16x32_bf16 v[176:179], v[40:43], v[96:99], v[176:179]
    ds_read_b64_tr_b16 v[106:107], v7 offset:9216
    ds_read_b64_tr_b16 v[120:121], v7 offset:24576
    v_mfma_f32_16x16x32_bf16 v[180:183], v[48:51], v[96:99], v[180:183]
    ds_read_b64_tr_b16 v[122:123], v7 offset:25600
    v_mfma_f32_16x16x32_bf16 v[180:183], v[56:59], v[112:115], v[180:183]
    v_mfma_f32_16x16x32_bf16 v[180:183], v[64:67], v[128:131], v[180:183]
    s_waitcnt lgkmcnt(9)
    v_mfma_f32_16x16x32_bf16 v[132:135], v[20:23], v[100:103], v[132:135]
    v_mfma_f32_16x16x32_bf16 v[132:135], v[28:31], v[116:119], v[132:135]
    v_mfma_f32_16x16x32_bf16 v[136:139], v[36:39], v[116:119], v[136:139]
    v_mfma_f32_16x16x32_bf16 v[136:139], v[28:31], v[100:103], v[136:139]
    v_mfma_f32_16x16x32_bf16 v[140:143], v[36:39], v[100:103], v[140:143]
    v_mfma_f32_16x16x32_bf16 v[140:143], v[44:47], v[116:119], v[140:143]
    s_waitcnt lgkmcnt(0)
    v_mfma_f32_16x16x32_bf16 v[144:147], v[52:55], v[116:119], v[144:147]
    v_mfma_f32_16x16x32_bf16 v[144:147], v[44:47], v[100:103], v[144:147]
    v_mfma_f32_16x16x32_bf16 v[148:151], v[52:55], v[100:103], v[148:151]
    v_mfma_f32_16x16x32_bf16 v[148:151], v[60:63], v[116:119], v[148:151]
    ds_write_b64 v10, v[132:133] offset:0
    v_mfma_f32_16x16x32_bf16 v[152:155], v[68:71], v[116:119], v[152:155]
    ds_write_b64 v10, v[134:135] offset:512
    v_mfma_f32_16x16x32_bf16 v[152:155], v[60:63], v[100:103], v[152:155]
    ds_write_b64 v10, v[136:137] offset:1024
    v_mfma_f32_16x16x32_bf16 v[156:159], v[68:71], v[100:103], v[156:159]
    ds_write_b64 v10, v[138:139] offset:1536
    v_mfma_f32_16x16x32_bf16 v[156:159], v[76:79], v[116:119], v[156:159]
    ds_write_b64 v10, v[140:141] offset:2048
    v_mfma_f32_16x16x32_bf16 v[160:163], v[84:87], v[116:119], v[160:163]
    ds_write_b64 v10, v[142:143] offset:2560
    v_mfma_f32_16x16x32_bf16 v[160:163], v[76:79], v[100:103], v[160:163]
    ds_write_b64 v10, v[144:145] offset:3072
    v_mfma_f32_16x16x32_bf16 v[184:187], v[72:75], v[128:131], v[184:187]
    ds_write_b64 v10, v[146:147] offset:3584
    v_mfma_f32_16x16x32_bf16 v[184:187], v[64:67], v[112:115], v[184:187]
    ds_write_b64 v10, v[148:149] offset:4096
    v_mfma_f32_16x16x32_bf16 v[184:187], v[56:59], v[96:99], v[184:187]
    ds_write_b64 v10, v[150:151] offset:4608
    v_mfma_f32_16x16x32_bf16 v[188:191], v[64:67], v[96:99], v[188:191]
    ds_write_b64 v10, v[152:153] offset:5120
    v_mfma_f32_16x16x32_bf16 v[188:191], v[72:75], v[112:115], v[188:191]
    ds_write_b64 v10, v[154:155] offset:5632
    v_mfma_f32_16x16x32_bf16 v[188:191], v[80:83], v[128:131], v[188:191]
    ds_write_b64 v10, v[156:157] offset:6144
    v_mfma_f32_16x16x32_bf16 v[192:195], v[88:91], v[128:131], v[192:195]
    ds_write_b64 v10, v[158:159] offset:6656
    v_mfma_f32_16x16x32_bf16 v[192:195], v[80:83], v[112:115], v[192:195]
    ds_write_b64 v10, v[160:161] offset:7168
    v_mfma_f32_16x16x32_bf16 v[192:195], v[72:75], v[96:99], v[192:195]
    ds_write_b64 v10, v[162:163] offset:7680
    v_mfma_f32_16x16x32_bf16 v[164:167], v[20:23], v[104:107], v[164:167]
    v_mfma_f32_16x16x32_bf16 v[164:167], v[28:31], v[120:123], v[164:167]
    v_mfma_f32_16x16x32_bf16 v[168:171], v[36:39], v[120:123], v[168:171]
    v_mfma_f32_16x16x32_bf16 v[168:171], v[28:31], v[104:107], v[168:171]
    s_waitcnt lgkmcnt(0)
    s_barrier
    ds_read_b32 v13, v12
    ds_read2st64_b64 v[132:135], v11 offset0:0 offset1:1
    ds_read2st64_b64 v[136:139], v11 offset0:2 offset1:3
    v_mfma_f32_16x16x32_bf16 v[172:175], v[36:39], v[104:107], v[172:175]
    ds_read2st64_b64 v[140:143], v11 offset0:4 offset1:5
    ds_read2st64_b64 v[144:147], v11 offset0:6 offset1:7
    v_mfma_f32_16x16x32_bf16 v[172:175], v[44:47], v[120:123], v[172:175]
    ds_read2st64_b64 v[148:151], v11 offset0:8 offset1:9
    ds_read2st64_b64 v[152:155], v11 offset0:10 offset1:11
    v_mfma_f32_16x16x32_bf16 v[176:179], v[52:55], v[120:123], v[176:179]
    ds_read2st64_b64 v[156:159], v11 offset0:12 offset1:13
    ds_read2st64_b64 v[160:163], v11 offset0:14 offset1:15
    v_mfma_f32_16x16x32_bf16 v[176:179], v[44:47], v[104:107], v[176:179]
    v_mfma_f32_16x16x32_bf16 v[180:183], v[52:55], v[104:107], v[180:183]
    v_mfma_f32_16x16x32_bf16 v[180:183], v[60:63], v[120:123], v[180:183]
    v_mfma_f32_16x16x32_bf16 v[184:187], v[68:71], v[120:123], v[184:187]
    v_mfma_f32_16x16x32_bf16 v[184:187], v[60:63], v[104:107], v[184:187]
    v_mfma_f32_16x16x32_bf16 v[188:191], v[68:71], v[104:107], v[188:191]
    v_mfma_f32_16x16x32_bf16 v[188:191], v[76:79], v[120:123], v[188:191]
    v_mfma_f32_16x16x32_bf16 v[192:195], v[84:87], v[120:123], v[192:195]
    v_mfma_f32_16x16x32_bf16 v[192:195], v[76:79], v[104:107], v[192:195]
    s_waitcnt lgkmcnt(0)
    v_pk_add_f32 v[164:165], v[164:165], v[132:133]
    v_pk_add_f32 v[166:167], v[166:167], v[134:135]
    v_pk_add_f32 v[8:9], v[164:165], v[166:167]
    v_pk_mul_f32 v[196:197], v[164:165], v[164:165]
    v_pk_fma_f32 v[196:197], v[166:167], v[166:167], v[196:197]
    v_pk_add_f32 v[168:169], v[168:169], v[136:137]
    v_pk_add_f32 v[170:171], v[170:171], v[138:139]
    v_pk_add_f32 v[8:9], v[8:9], v[168:169]
    v_pk_fma_f32 v[196:197], v[168:169], v[168:169], v[196:197]
    v_pk_add_f32 v[8:9], v[8:9], v[170:171]
    v_pk_fma_f32 v[196:197], v[170:171], v[170:171], v[196:197]
    v_pk_add_f32 v[172:173], v[172:173], v[140:141]
    v_pk_add_f32 v[174:175], v[174:175], v[142:143]
    v_pk_add_f32 v[8:9], v[8:9], v[172:173]
    v_pk_fma_f32 v[196:197], v[172:173], v[172:173], v[196:197]
    v_pk_add_f32 v[8:9], v[8:9], v[174:175]
    v_pk_fma_f32 v[196:197], v[174:175], v[174:175], v[196:197]
    v_pk_add_f32 v[176:177], v[176:177], v[144:145]
    v_pk_add_f32 v[178:179], v[178:179], v[146:147]
    v_pk_add_f32 v[8:9], v[8:9], v[176:177]
    v_pk_fma_f32 v[196:197], v[176:177], v[176:177], v[196:197]
    v_pk_add_f32 v[8:9], v[8:9], v[178:179]
    v_pk_fma_f32 v[196:197], v[178:179], v[178:179], v[196:197]
    v_pk_add_f32 v[180:181], v[180:181], v[148:149]
    v_pk_add_f32 v[182:183], v[182:183], v[150:151]
    v_pk_add_f32 v[8:9], v[8:9], v[180:181]
    v_pk_fma_f32 v[196:197], v[180:181], v[180:181], v[196:197]
    v_pk_add_f32 v[8:9], v[8:9], v[182:183]
    v_pk_fma_f32 v[196:197], v[182:183], v[182:183], v[196:197]
    v_pk_add_f32 v[184:185], v[184:185], v[152:153]
    v_pk_add_f32 v[186:187], v[186:187], v[154:155]
    v_pk_add_f32 v[8:9], v[8:9], v[184:185]
    v_pk_fma_f32 v[196:197], v[184:185], v[184:185], v[196:197]
    v_pk_add_f32 v[8:9], v[8:9], v[186:187]
    v_pk_fma_f32 v[196:197], v[186:187], v[186:187], v[196:197]
    v_pk_add_f32 v[188:189], v[188:189], v[156:157]
    v_pk_add_f32 v[190:191], v[190:191], v[158:159]
    v_cndmask_b32 v189, v189, 0, s[34:35]
    v_pk_add_f32 v[8:9], v[8:9], v[188:189]
    v_pk_fma_f32 v[196:197], v[188:189], v[188:189], v[196:197]
    v_pk_add_f32 v[8:9], v[8:9], v[190:191]
    v_pk_fma_f32 v[196:197], v[190:191], v[190:191], v[196:197]
    v_pk_add_f32 v[192:193], v[192:193], v[160:161]
    v_pk_add_f32 v[194:195], v[194:195], v[162:163]
    v_cndmask_b32 v193, v193, 0, s[34:35]
    v_pk_add_f32 v[8:9], v[8:9], v[192:193]
    v_pk_fma_f32 v[196:197], v[192:193], v[192:193], v[196:197]
    v_pk_add_f32 v[8:9], v[8:9], v[194:195]
    v_pk_fma_f32 v[196:197], v[194:195], v[194:195], v[196:197]
    v_add_f32 v4, v8, v9
    v_add_f32 v6, v196, v197
    s_nop 1
    v_permlane32_swap_b32 v4, v6
    v_add_f32 v5, v4, v6
    v_add_f32 v4, v4, v6
    s_nop 1
    v_permlane16_swap_b32 v4, v5
    s_mov_b32 exec_lo, 0xffff
    s_mov_b32 exec_hi, 0xffff
    v_add_f32 v12, v4, v5
    v_xor_b32 v13, v13, v12
    global_store_dwordx2 v1, v[12:13], s[18:19]
    s_mov_b64 exec, -1
    ds_write2st64_b32 v15, v164, v165 offset0:0 offset1:8
    s_lshl_b32 s58, s3, 12
    s_and_b32 s59, s3, 2
    ds_write2st64_b32 v15, v166, v167 offset0:16 offset1:24
    s_lshl_b32 s59, s59, 5
    v_lshl_add_u32 v4, v0, 4, s58
    ds_write2st64_b32 v15, v168, v169 offset0:1 offset1:9
    v_xor_b32 v4, s59, v4
    v_and_b32 v3, 15, v0
    ds_write2st64_b32 v15, v170, v171 offset0:17 offset1:25
    v_lshlrev_b32 v5, 4, v3
    v_add_u32 v5, 0x10000, v5
    ds_write2st64_b32 v15, v172, v173 offset0:2 offset1:10
    s_mul_i32 s58, s44, 2045952
    s_add_u32 s30, s58, 2045952
    ds_write2st64_b32 v15, v174, v175 offset0:18 offset1:26
    s_mov_b32 s31, 0x20000
    s_mov_b32 s28, s14
    ds_write2st64_b32 v15, v176, v177 offset0:3 offset1:11
    s_mov_b32 s29, s15
    s_lshl_b32 s59, s45, 17
    ds_write2st64_b32 v15, v178, v179 offset0:19 offset1:27
    s_add_u32 s58, s58, s59
    s_add_u32 s58, s58, s51
    ds_write2st64_b32 v15, v180, v181 offset0:4 offset1:12
    s_lshl_b32 s59, s3, 14
    s_add_u32 s40, s58, s59
    ds_write2st64_b32 v15, v182, v183 offset0:20 offset1:28
    s_add_u32 s41, s40, 0x1000
    s_add_u32 s42, s40, 0x2000
    ds_write2st64_b32 v15, v184, v185 offset0:5 offset1:13
    s_add_u32 s43, s40, 0x3000
    v_lshrrev_b32 v2, 4, v0
    ds_write2st64_b32 v15, v186, v187 offset0:21 offset1:29
    v_lshlrev_b32 v6, 10, v2
    v_lshl_add_u32 v6, v3, 3, v6
    ds_write2st64_b32 v15, v188, v189 offset0:6 offset1:14
    s_mov_b32 s52, 0xbdd2d3e8
    s_mov_b32 s53, 0xc0135761
    ds_write2st64_b32 v15, v190, v191 offset0:22 offset1:30
    s_mov_b32 s54, 0xffff
    s_mov_b32 s55, 0xffff
    ds_write2st64_b32 v15, v192, v193 offset0:7 offset1:15
    ds_write2st64_b32 v15, v194, v195 offset0:23 offset1:31
    s_waitcnt lgkmcnt(0)
    s_barrier
    ds_read_b128 v[16:19], v5
    ds_read_b128 v[24:27], v5 offset:256
    ds_read_b128 v[40:43], v4 offset:32768
    ds_read_b128 v[44:47], v4 offset:33792
    ds_read_b128 v[48:51], v4 offset:34816
    ds_read_b128 v[52:55], v4 offset:35840
L_final:
    s_waitcnt lgkmcnt(3)
    v_pk_fma_f32 v[40:41], v[40:41], v[16:17], v[24:25]
    v_pk_fma_f32 v[42:43], v[42:43], v[18:19], v[26:27]
    v_pk_mul_f32 v[56:57], v[40:41], v[40:41]
    v_pk_mul_f32 v[58:59], v[42:43], v[42:43]
    v_pk_fma_f32 v[56:57], v[56:57], s[52:53], s[52:53] op_sel:[0,0,1] op_sel_hi:[1,0,1]
    v_pk_fma_f32 v[58:59], v[58:59], s[52:53], s[52:53] op_sel:[0,0,1] op_sel_hi:[1,0,1]
    v_pk_mul_f32 v[56:57], v[56:57], v[40:41]
    v_pk_mul_f32 v[58:59], v[58:59], v[42:43]
    v_exp_f32 v56, v56
    v_exp_f32 v57, v57
    v_exp_f32 v58, v58
    v_exp_f32 v59, v59
    v_pk_add_f32 v[56:57], v[56:57], 1.0 op_sel_hi:[1,0]
    v_pk_add_f32 v[58:59], v[58:59], 1.0 op_sel_hi:[1,0]
    v_rcp_f32 v56, v56
    v_rcp_f32 v57, v57
    v_rcp_f32 v58, v58
    v_rcp_f32 v59, v59
    v_pk_mul_f32 v[40:41], v[40:41], v[56:57]
    v_pk_mul_f32 v[42:43], v[42:43], v[58:59]
    v_cvt_pk_bf16_f32 v72, v40, v41
    v_cvt_pk_bf16_f32 v73, v42, v43
    buffer_store_dwordx2 v[72:73], v6, s[28:31], s40 offen sc0 sc1
    s_waitcnt lgkmcnt(2)
    v_pk_fma_f32 v[44:45], v[44:45], v[16:17], v[24:25]
    v_pk_fma_f32 v[46:47], v[46:47], v[18:19], v[26:27]
    v_pk_mul_f32 v[60:61], v[44:45], v[44:45]
    v_pk_mul_f32 v[62:63], v[46:47], v[46:47]
    v_pk_fma_f32 v[60:61], v[60:61], s[52:53], s[52:53] op_sel:[0,0,1] op_sel_hi:[1,0,1]
    v_pk_fma_f32 v[62:63], v[62:63], s[52:53], s[52:53] op_sel:[0,0,1] op_sel_hi:[1,0,1]
    v_pk_mul_f32 v[60:61], v[60:61], v[44:45]
    v_pk_mul_f32 v[62:63], v[62:63], v[46:47]
    v_exp_f32 v60, v60
    v_exp_f32 v61, v61
    v_exp_f32 v62, v62
    v_exp_f32 v63, v63
    v_pk_add_f32 v[60:61], v[60:61], 1.0 op_sel_hi:[1,0]
    v_pk_add_f32 v[62:63], v[62:63], 1.0 op_sel_hi:[1,0]
    v_rcp_f32 v60, v60
    v_rcp_f32 v61, v61
    v_rcp_f32 v62, v62
    v_rcp_f32 v63, v63
    v_pk_mul_f32 v[44:45], v[44:45], v[60:61]
    v_pk_mul_f32 v[46:47], v[46:47], v[62:63]
    v_cvt_pk_bf16_f32 v74, v44, v45
    v_cvt_pk_bf16_f32 v75, v46, v47
    buffer_store_dwordx2 v[74:75], v6, s[28:31], s41 offen sc0 sc1
    s_waitcnt lgkmcnt(1)
    v_pk_fma_f32 v[48:49], v[48:49], v[16:17], v[24:25]
    v_pk_fma_f32 v[50:51], v[50:51], v[18:19], v[26:27]
    v_pk_mul_f32 v[64:65], v[48:49], v[48:49]
    v_pk_mul_f32 v[66:67], v[50:51], v[50:51]
    v_pk_fma_f32 v[64:65], v[64:65], s[52:53], s[52:53] op_sel:[0,0,1] op_sel_hi:[1,0,1]
    v_pk_fma_f32 v[66:67], v[66:67], s[52:53], s[52:53] op_sel:[0,0,1] op_sel_hi:[1,0,1]
    v_pk_mul_f32 v[64:65], v[64:65], v[48:49]
    v_pk_mul_f32 v[66:67], v[66:67], v[50:51]
    v_exp_f32 v64, v64
    v_exp_f32 v65, v65
    v_exp_f32 v66, v66
    v_exp_f32 v67, v67
    v_pk_add_f32 v[64:65], v[64:65], 1.0 op_sel_hi:[1,0]
    v_pk_add_f32 v[66:67], v[66:67], 1.0 op_sel_hi:[1,0]
    v_rcp_f32 v64, v64
    v_rcp_f32 v65, v65
    v_rcp_f32 v66, v66
    v_rcp_f32 v67, v67
    v_pk_mul_f32 v[48:49], v[48:49], v[64:65]
    v_pk_mul_f32 v[50:51], v[50:51], v[66:67]
    v_cvt_pk_bf16_f32 v76, v48, v49
    v_cvt_pk_bf16_f32 v77, v50, v51
    buffer_store_dwordx2 v[76:77], v6, s[28:31], s42 offen sc0 sc1
    s_waitcnt lgkmcnt(0)
    v_pk_fma_f32 v[52:53], v[52:53], v[16:17], v[24:25]
    v_pk_fma_f32 v[54:55], v[54:55], v[18:19], v[26:27]
    v_pk_mul_f32 v[68:69], v[52:53], v[52:53]
    v_pk_mul_f32 v[70:71], v[54:55], v[54:55]
    v_pk_fma_f32 v[68:69], v[68:69], s[52:53], s[52:53] op_sel:[0,0,1] op_sel_hi:[1,0,1]
    v_pk_fma_f32 v[70:71], v[70:71], s[52:53], s[52:53] op_sel:[0,0,1] op_sel_hi:[1,0,1]
    v_pk_mul_f32 v[68:69], v[68:69], v[52:53]
    v_pk_mul_f32 v[70:71], v[70:71], v[54:55]
    v_exp_f32 v68, v68
    v_exp_f32 v69, v69
    v_exp_f32 v70, v70
    v_exp_f32 v71, v71
    v_pk_add_f32 v[68:69], v[68:69], 1.0 op_sel_hi:[1,0]
    v_pk_add_f32 v[70:71], v[70:71], 1.0 op_sel_hi:[1,0]
    v_rcp_f32 v68, v68
    v_rcp_f32 v69, v69
    v_rcp_f32 v70, v70
    v_rcp_f32 v71, v71
    v_pk_mul_f32 v[52:53], v[52:53], v[68:69]
    v_pk_mul_f32 v[54:55], v[54:55], v[70:71]
    v_cvt_pk_bf16_f32 v78, v52, v53
    v_cvt_pk_bf16_f32 v79, v54, v55
    buffer_store_dwordx2 v[78:79], v6, s[28:31], s43 offen sc0 sc1
    s_mov_b64 exec, s[54:55]
    s_cbranch_execz L_nl
    global_store_dwordx2 v1, v[12:13], s[18:19] sc0 sc1
L_nl:
    s_mov_b64 exec, -1
L_noep:
L_end:
    s_endpgm
L_fb:
    s_mov_b64 exec, -1
    s_cmp_ge_u32 s58, 0x200000
    s_cbranch_scc1 L_ps_ok
    s_sleep 16
    v_mov_b32 v12, v13
    s_andn2_b64 exec, -1, s[64:65]
    s_cbranch_execz L_fk0
    global_store_dwordx4 v12, v[20:23], s[18:19] offset:0 sc0 sc1
L_fk0:
    s_andn2_b64 exec, -1, s[66:67]
    s_cbranch_execz L_fk1
    global_store_dwordx4 v12, v[24:27], s[18:19] offset:1024 sc0 sc1
L_fk1:
    s_andn2_b64 exec, -1, s[68:69]
    s_cbranch_execz L_fk2
    global_store_dwordx4 v12, v[28:31], s[18:19] offset:2048 sc0 sc1
L_fk2:
    s_andn2_b64 exec, -1, s[70:71]
    s_cbranch_execz L_fk3
    global_store_dwordx4 v12, v[32:35], s[18:19] offset:3072 sc0 sc1
L_fk3:
    s_mov_b64 exec, -1
    s_and_b32 s72, s58, 255
    s_cbranch_scc1 L_fbr
    v_mov_b32 v12, 0
    s_mov_b64 exec, s[64:65]
    s_cbranch_execz L_fa0
    global_atomic_or v13, v12, s[18:19] offset:0 sc1
L_fa0:
    s_mov_b64 exec, s[66:67]
    s_cbranch_execz L_fa1
    global_atomic_or v13, v12, s[18:19] offset:1024 sc1
L_fa1:
    s_mov_b64 exec, s[68:69]
    s_cbranch_execz L_fa2
    global_atomic_or v13, v12, s[18:19] offset:2048 sc1
L_fa2:
    s_mov_b64 exec, s[70:71]
    s_cbranch_execz L_fa3
    global_atomic_or v13, v12, s[18:19] offset:3072 sc1
L_fa3:
    s_waitcnt vmcnt(0)
    s_branch L_fbr
L_codeend:
.section .rodata,"a"
.p2align 6
.amdhsa_kernel standalone__self_sup_conv_stem_hubert__speech_kernel
  .amdhsa_next_free_vgpr 200
  .amdhsa_next_free_sgpr 96
  .amdhsa_accum_offset 200
  .amdhsa_group_segment_fixed_size 0
  .amdhsa_kernarg_size 64
  .amdhsa_user_sgpr_count 2
  .amdhsa_user_sgpr_kernarg_segment_ptr 1
  .amdhsa_system_sgpr_workgroup_id_x 1
  .amdhsa_float_denorm_mode_32 3
.end_amdhsa_kernel
```
